```python
import torch

def _softmax(x, axis=-1):
    return torch.softmax(x, dim=axis)
def _gelu(x):
    return torch.nn.functional.gelu(x, approximate="tanh")
def _silu(x):
    return torch.nn.functional.silu(x)
def _sigmoid(x):
    return torch.sigmoid(x)
def _layernorm(x, axis=-1, eps=1e-5):
    m = x.mean(dim=axis, keepdim=True)
    v = x.var(dim=axis, keepdim=True, unbiased=False)
    return (x - m) / torch.sqrt(v + eps)
def _scatter_add(tgt, idx, src, axis=0):
    return tgt.clone().index_add_(axis, idx, src)
def _segment_sum(src, seg, n):
    out = torch.zeros((n,) + src.shape[1:], dtype=src.dtype)
    return out.index_add_(0, seg, src)
def _pad(x, pw):
    flat = tuple(v for pair in reversed(pw) for v in pair)
    return torch.nn.functional.pad(x, flat)

kernel_name = 'gated_mix__sliding_block_cached__glu_gated_swiglu__decode'

def setup_inputs():

    _w = (lambda a: (lambda t: t.to(torch.bfloat16) if t.is_floating_point() else t)(torch.as_tensor(a)))
    def _A_setup():
        B, Sq, D = 4, 1, 512
        Hq, Hkv, Sk, Dh = 32, 8, 8192, 128
        assert Hq % Hkv == 0, (Hq, Hkv)
        return {
            "x": _w((lambda *s: torch.randn(*s, dtype=torch.bfloat16) * 0.05)(B, Sq, D)),
            "k_cache": _w((lambda *s: torch.randn(*s, dtype=torch.bfloat16) * 6.4)(B, Hkv, Sk, Dh)),
            "v_cache": _w((lambda *s: torch.randn(*s, dtype=torch.bfloat16) * 0.05)(B, Hkv, Sk, Dh)),
            "wq": _w((lambda *s: torch.randn(*s, dtype=torch.bfloat16) * 6.4)(D, Hq * Dh) * (D ** -0.5)),
            "wo": _w((lambda *s: torch.randn(*s, dtype=torch.bfloat16) * 0.05)(Hq * Dh, D) * ((Hq * Dh) ** -0.5)),
        }
    _A_in = _A_setup()

    def _B_setup():
        B, S, D, F = 4, 1, 512, 1792
        return {
            "x": _w((lambda *s: torch.randn(*s, dtype=torch.bfloat16) * 0.05)(B, S, D)),
            "w1": _w((lambda *s: torch.randn(*s, dtype=torch.bfloat16) * 0.4)(D, F) * (2.0 / D) ** 0.5),
            "w3": _w((lambda *s: torch.randn(*s, dtype=torch.bfloat16) * 0.4)(D, F) * (2.0 / D) ** 0.5),
            "w2": _w((lambda *s: torch.randn(*s, dtype=torch.bfloat16) * 0.4)(F, D) * (2.0 / F) ** 0.5),
        }
    _B_in = _B_setup()

    return {
        "A_x": _A_in["x"],
        "A_k_cache": _A_in["k_cache"],
        "A_v_cache": _A_in["v_cache"],
        "A_wq": _A_in["wq"],
        "A_wo": _A_in["wo"],
        "B_x": _B_in["x"],
        "B_w1": _B_in["w1"],
        "B_w3": _B_in["w3"],
        "B_w2": _B_in["w2"],
        "gate_w": _w((lambda *s: torch.randn(*s, dtype=torch.bfloat16) * 0.05)(512) * 16.0),
    }

def reference(A_x, A_k_cache, A_v_cache, A_wq, A_wo, B_x, B_w1, B_w3, B_w2, gate_w):
    def _A_ref(x, k_cache, v_cache, wq, wo):
        B, Sq, D = x.shape
        Hq, Dh = 32, 128
        Hkv, Sk = k_cache.shape[1], k_cache.shape[2]
        W = min(4096, max(256, Sk // 4))
        rep = Hq // Hkv
        q = (lambda x, *d: x.permute(*d))((x @ wq).reshape(B, Sq, Hq, Dh), 0, 2, 1, 3)
        k = (lambda x, n, axis: torch.repeat_interleave(x, n, dim=axis))(k_cache[:, :, Sk - W:, :], rep, axis=1)
        v = (lambda x, n, axis: torch.repeat_interleave(x, n, dim=axis))(v_cache[:, :, Sk - W:, :], rep, axis=1)
        scores = torch.einsum("bhqd,bhkd->bhqk", q, k) * (Dh ** -0.5)
        p = _softmax(scores, axis=-1)
        o = torch.einsum("bhqk,bhkd->bhqd", p, v)
        return (lambda x, *d: x.permute(*d))(o, 0, 2, 1, 3).reshape(B, Sq, Hq * Dh) @ wo

    def _B_ref(x, w1, w3, w2):
        gate = torch.einsum("bsd,df->bsf", x, w1)
        up = torch.einsum("bsd,df->bsf", x, w3)
        h = _silu(gate) * up
        out = torch.einsum("bsf,fd->bsd", h, w2)
        return out

    x = A_x
    g = _sigmoid((x * gate_w).sum(-1, keepdims=True))
    a = _A_ref(x, A_k_cache, A_v_cache, A_wq, A_wo)
    b = _B_ref(x, B_w1, B_w3, B_w2)
    return g * a + (1 - g) * b
```

```asm
; @launch grid=(256,1,1) block=(768,1,1) lds=18432
.amdgcn_target "amdgcn-amd-amdhsa--gfx950"
.text
.globl gated_mix__sliding_block_cached__glu_gated_swiglu__decode_kernel
.p2align 8
.type gated_mix__sliding_block_cached__glu_gated_swiglu__decode_kernel,@function
gated_mix__sliding_block_cached__glu_gated_swiglu__decode_kernel:
    s_cmp_ge_u32 s2, 256
    s_cbranch_scc1 L_end
    v_lshrrev_b32 v1, 6, v0
    v_and_b32 v2, 63, v0
    v_readfirstlane_b32 s3, v1
    s_and_b32 s4, s2, 7
    s_lshr_b32 s5, s2, 3
    s_lshr_b32 s6, s5, 3
    s_and_b32 s7, s5, 7
    s_lshl_b32 s18, s4, 3
    s_add_u32 s18, s18, s7
    s_mov_b32 s66, 0x05040100
    s_mov_b32 s67, 0x07060302
    s_load_dwordx2 s[52:53], s[0:1], 96
    s_mov_b32 s54, 268435456
    s_mov_b32 s55, 0x20000
    s_mov_b32 s99, s3
    s_cmp_lt_u32 s3, 4
    s_cbranch_scc1 L_K
    s_cmp_ge_u32 s3, 8
    s_cbranch_scc1 L_O
    s_load_dwordx2 s[40:41], s[0:1], 16
    s_sub_u32 s3, s3, 4
    s_cmp_ge_u32 s3, 2
    s_cbranch_scc1 L_V23
    s_load_dwordx2 s[48:49], s[0:1], 0
    s_setprio 3
    s_cmp_eq_u32 s3, 0
    s_cbranch_scc0 L_W1setup
    s_load_dwordx2 s[44:45], s[0:1], 24
    s_mov_b32 s46, 4194304
    s_movk_i32 s10, 8192
    s_lshl_b32 s9, s6, 20
    s_lshl_b32 s11, s7, 7
    s_add_u32 s9, s9, s11
    s_lshl_b32 s11, s4, 10
    s_add_u32 s9, s9, s11
    s_lshl_b32 s11, s6, 8
    s_lshl_b32 s12, s4, 16
    s_lshl_b32 s13, s6, 12
    s_add_u32 s12, s12, s13
    s_lshl_b32 s13, s7, 9
    s_add_u32 s12, s12, s13

    s_add_u32 s12, s12, 65536
    s_movk_i32 s13, 16384
    s_movk_i32 s16, 256
    s_mov_b32 s19, 0
    s_branch L_prod
L_W1setup:
    s_add_u32 s19, s5, 4
    s_lshr_b32 s19, s19, 3
    s_sub_u32 s19, s5, s19
    s_mul_i32 s8, s4, 28
    s_add_u32 s19, s19, s8
    s_cmp_eq_u32 s7, 3
    s_cselect_b32 s19, 255, s19
    s_and_b32 s8, s19, 1
    s_cmp_eq_u32 s8, 0
    s_cbranch_scc0 L_W1b
    s_load_dwordx2 s[44:45], s[0:1], 48
    s_branch L_W1c
L_W1b:
    s_load_dwordx2 s[44:45], s[0:1], 56
L_W1c:
    s_mov_b32 s46, 1835008
    s_movk_i32 s10, 3584
    s_lshr_b32 s9, s19, 1
    s_mul_i32 s11, s9, 2341
    s_lshr_b32 s11, s11, 16
    s_mul_i32 s12, s11, 28
    s_sub_u32 s12, s9, s12
    s_mul_i32 s9, s11, 458752
    s_lshl_b32 s13, s12, 7
    s_add_u32 s9, s9, s13
    s_mul_i32 s13, s8, 229376
    s_lshl_b32 s12, s12, 9
    s_add_u32 s12, s12, s13
    s_mul_i32 s13, s11, 57344
    s_add_u32 s12, s12, s13
    s_add_u32 s12, s12, 1048576
    s_movk_i32 s13, 14336
    s_lshl_b32 s11, s11, 8
    s_movk_i32 s16, 224
L_prod:
    s_mov_b32 s50, 4096
    s_mov_b32 s51, 0x20000
    s_mov_b32 s47, 0x20000
    v_lshrrev_b32 v3, 3, v2
    v_and_b32 v4, 7, v2
    v_lshlrev_b32 v4, 4, v4
    s_lshl_b32 s8, s10, 3
    v_mul_lo_u32 v5, v3, s8
    v_add_u32 v5, v5, v4
    v_and_b32 v6, 15, v2
    v_lshrrev_b32 v7, 2, v6
    v_lshlrev_b32 v7, 10, v7
    v_and_b32 v8, 1, v2
    v_lshrrev_b32 v9, 4, v2
    v_lshl_add_u32 v8, v9, 1, v8
    v_lshl_add_u32 v7, v8, 4, v7
    v_mul_lo_u32 v10, v9, s13
    v_lshl_add_u32 v10, v6, 4, v10
    v_cmp_le_u32 s[68:69], 8, v6
    s_mul_i32 s17, s10, 57
    s_cmp_ge_u32 s19, s16
    s_waitcnt lgkmcnt(0)
    s_nop 0
    s_cbranch_scc1 L_prod_skip
    buffer_load_dwordx4 v[80:83], v7, s[48:51], s11 offen
    buffer_load_dwordx4 v[84:87], v7, s[48:51], s11 offen offset:128
    s_mov_b32 s14, s9
    buffer_load_dwordx4 v[16:19], v5, s[44:47], s14 offen nt
    s_add_u32 s14, s14, s10
    buffer_load_dwordx4 v[20:23], v5, s[44:47], s14 offen nt
    s_add_u32 s14, s14, s10
    buffer_load_dwordx4 v[24:27], v5, s[44:47], s14 offen nt
    s_add_u32 s14, s14, s10
    buffer_load_dwordx4 v[28:31], v5, s[44:47], s14 offen nt
    s_add_u32 s14, s14, s10
    buffer_load_dwordx4 v[32:35], v5, s[44:47], s14 offen nt
    s_add_u32 s14, s14, s10
    buffer_load_dwordx4 v[36:39], v5, s[44:47], s14 offen nt
    s_add_u32 s14, s14, s10
    buffer_load_dwordx4 v[40:43], v5, s[44:47], s14 offen nt
    s_add_u32 s14, s14, s10
    buffer_load_dwordx4 v[44:47], v5, s[44:47], s14 offen nt
    s_add_u32 s14, s14, s17
    buffer_load_dwordx4 v[48:51], v5, s[44:47], s14 offen nt
    s_add_u32 s14, s14, s10
    buffer_load_dwordx4 v[52:55], v5, s[44:47], s14 offen nt
    s_add_u32 s14, s14, s10
    buffer_load_dwordx4 v[56:59], v5, s[44:47], s14 offen nt
    s_add_u32 s14, s14, s10
    buffer_load_dwordx4 v[60:63], v5, s[44:47], s14 offen nt
    s_add_u32 s14, s14, s10
    buffer_load_dwordx4 v[64:67], v5, s[44:47], s14 offen nt
    s_add_u32 s14, s14, s10
    buffer_load_dwordx4 v[68:71], v5, s[44:47], s14 offen nt
    s_add_u32 s14, s14, s10
    buffer_load_dwordx4 v[72:75], v5, s[44:47], s14 offen nt
    s_add_u32 s14, s14, s10
    buffer_load_dwordx4 v[76:79], v5, s[44:47], s14 offen nt
    s_load_dword s65, s[52:53], 0
    s_barrier
    s_cmp_eq_u32 s3, 0
    s_cbranch_scc0 L_prod_notag
    s_waitcnt lgkmcnt(0)
    s_mul_i32 s64, s65, 0x9E3779B1
    s_add_u32 s64, s64, 0x7F4A7C15
    v_mov_b32 v96, s64
    v_mov_b32 v97, 1
    v_mov_b32 v98, 0
    ds_write_b64 v98, v[96:97]
    s_branch L_prod_havetag
L_prod_notag:
    v_mov_b32 v98, 0
    s_mov_b32 s15, 0
Ltag_1:
    ds_read_b64 v[96:97], v98
    s_waitcnt lgkmcnt(0)
    v_readfirstlane_b32 s14, v97
    v_readfirstlane_b32 s64, v96
    s_add_u32 s15, s15, 1
    s_nop 1
    s_cmp_eq_u32 s14, 1
    s_cbranch_scc1 Ltagd_2
    s_cmp_lt_u32 s15, 16000000
    s_sleep 1
    s_cbranch_scc1 Ltag_1
Ltagd_2:
L_prod_havetag:
    v_mov_b32 v89, s64
    v_mov_b32 v91, s64
    v_mov_b32 v93, s64
    v_mov_b32 v95, s64
    s_waitcnt vmcnt(8)
    v_perm_b32 v96, v20, v16, s66
    v_perm_b32 v97, v28, v24, s66
    v_perm_b32 v98, v36, v32, s66
    v_perm_b32 v99, v44, v40, s66
    v_perm_b32 v100, v20, v16, s67
    v_perm_b32 v101, v28, v24, s67
    v_perm_b32 v102, v36, v32, s67
    v_perm_b32 v103, v44, v40, s67
    v_mfma_f32_16x16x32_bf16 v[112:115], v[80:83], v[96:99], 0
    v_perm_b32 v104, v21, v17, s66
    v_perm_b32 v105, v29, v25, s66
    v_perm_b32 v106, v37, v33, s66
    v_perm_b32 v107, v45, v41, s66
    v_mfma_f32_16x16x32_bf16 v[116:119], v[80:83], v[100:103], 0
    v_perm_b32 v96, v21, v17, s67
    v_perm_b32 v97, v29, v25, s67
    v_perm_b32 v98, v37, v33, s67
    v_perm_b32 v99, v45, v41, s67
    v_mfma_f32_16x16x32_bf16 v[120:123], v[80:83], v[104:107], 0
    v_perm_b32 v100, v22, v18, s66
    v_perm_b32 v101, v30, v26, s66
    v_perm_b32 v102, v38, v34, s66
    v_perm_b32 v103, v46, v42, s66
    v_mfma_f32_16x16x32_bf16 v[124:127], v[80:83], v[96:99], 0
    v_perm_b32 v104, v22, v18, s67
    v_perm_b32 v105, v30, v26, s67
    v_perm_b32 v106, v38, v34, s67
    v_perm_b32 v107, v46, v42, s67
    v_mfma_f32_16x16x32_bf16 v[128:131], v[80:83], v[100:103], 0
    v_perm_b32 v96, v23, v19, s66
    v_perm_b32 v97, v31, v27, s66
    v_perm_b32 v98, v39, v35, s66
    v_perm_b32 v99, v47, v43, s66
    v_mfma_f32_16x16x32_bf16 v[132:135], v[80:83], v[104:107], 0
    v_perm_b32 v100, v23, v19, s67
    v_perm_b32 v101, v31, v27, s67
    v_perm_b32 v102, v39, v35, s67
    v_perm_b32 v103, v47, v43, s67
    v_mfma_f32_16x16x32_bf16 v[136:139], v[80:83], v[96:99], 0
    s_nop 0
    v_mfma_f32_16x16x32_bf16 v[140:143], v[80:83], v[100:103], 0
    s_waitcnt vmcnt(0)
    v_perm_b32 v96, v52, v48, s66
    v_perm_b32 v97, v60, v56, s66
    v_perm_b32 v98, v68, v64, s66
    v_perm_b32 v99, v76, v72, s66
    v_perm_b32 v100, v52, v48, s67
    v_perm_b32 v101, v60, v56, s67
    v_perm_b32 v102, v68, v64, s67
    v_perm_b32 v103, v76, v72, s67
    v_mfma_f32_16x16x32_bf16 v[112:115], v[84:87], v[96:99], v[112:115]
    v_perm_b32 v104, v53, v49, s66
    v_perm_b32 v105, v61, v57, s66
    v_perm_b32 v106, v69, v65, s66
    v_perm_b32 v107, v77, v73, s66
    v_mfma_f32_16x16x32_bf16 v[116:119], v[84:87], v[100:103], v[116:119]
    v_perm_b32 v96, v53, v49, s67
    v_perm_b32 v97, v61, v57, s67
    v_perm_b32 v98, v69, v65, s67
    v_perm_b32 v99, v77, v73, s67
    v_mfma_f32_16x16x32_bf16 v[120:123], v[84:87], v[104:107], v[120:123]
    v_perm_b32 v100, v54, v50, s66
    v_perm_b32 v101, v62, v58, s66
    v_perm_b32 v102, v70, v66, s66
    v_perm_b32 v103, v78, v74, s66
    v_mfma_f32_16x16x32_bf16 v[124:127], v[84:87], v[96:99], v[124:127]
    v_perm_b32 v104, v54, v50, s67
    v_perm_b32 v105, v62, v58, s67
    v_perm_b32 v106, v70, v66, s67
    v_perm_b32 v107, v78, v74, s67
    v_mfma_f32_16x16x32_bf16 v[128:131], v[84:87], v[100:103], v[128:131]
    v_perm_b32 v96, v55, v51, s66
    v_perm_b32 v97, v63, v59, s66
    v_perm_b32 v98, v71, v67, s66
    v_perm_b32 v99, v79, v75, s66
    v_mfma_f32_16x16x32_bf16 v[132:135], v[84:87], v[104:107], v[132:135]
    v_perm_b32 v100, v55, v51, s67
    v_perm_b32 v101, v63, v59, s67
    v_perm_b32 v102, v71, v67, s67
    v_perm_b32 v103, v79, v75, s67
    v_mfma_f32_16x16x32_bf16 v[136:139], v[84:87], v[96:99], v[136:139]
    s_nop 0
    v_mfma_f32_16x16x32_bf16 v[140:143], v[84:87], v[100:103], v[140:143]
    v_cndmask_b32 v144, v112, v129, s[68:69]
    v_cndmask_b32 v148, v128, v113, s[68:69]
    v_cndmask_b32 v145, v116, v133, s[68:69]
    v_cndmask_b32 v149, v132, v117, s[68:69]
    s_nop 1
    v_cndmask_b32 v146, v120, v137, s[68:69]
    v_cndmask_b32 v150, v136, v121, s[68:69]
    v_cndmask_b32 v147, v124, v141, s[68:69]
    v_cndmask_b32 v151, v140, v125, s[68:69]
    v_add_f32_dpp v88, v148, v144 row_ror:8 row_mask:0xf bank_mask:0xf
    v_add_f32_dpp v90, v149, v145 row_ror:8 row_mask:0xf bank_mask:0xf
    v_add_f32_dpp v92, v150, v146 row_ror:8 row_mask:0xf bank_mask:0xf
    v_add_f32_dpp v94, v151, v147 row_ror:8 row_mask:0xf bank_mask:0xf
    s_cmp_eq_u32 s3, 0
    s_cbranch_scc0 L_nofastq
    s_add_u32 s29, s12, 5242880
    buffer_store_dwordx4 v[88:91], v10, s[52:55], s29 offen
    buffer_store_dwordx4 v[92:95], v10, s[52:55], s29 offen offset:256
L_nofastq:
    buffer_store_dwordx4 v[88:91], v10, s[52:55], s12 offen sc1
    buffer_store_dwordx4 v[92:95], v10, s[52:55], s12 offen offset:256 sc1
    s_nop 0
    s_branch L_V
L_prod_skip:
    s_barrier
    s_branch L_V
L_V23:
    s_cmp_eq_u32 s3, 3
    s_cbranch_scc1 L_W3
    s_barrier
    s_branch L_V
L_W3:
    s_load_dwordx2 s[48:49], s[0:1], 0
    s_load_dwordx2 s[44:45], s[0:1], 72
    s_setprio 3
    v_mov_b32 v4, 0
    v_mov_b32 v5, 0
    v_mov_b32 v6, 0
    v_mov_b32 v7, 0
    v_mov_b32 v8, 0
    ds_write_b128 v8, v[4:7]
    ds_write_b128 v8, v[4:7] offset:16
    ds_write_b128 v8, v[4:7] offset:32
    ds_write_b128 v8, v[4:7] offset:48
    s_mov_b32 s50, 4096
    s_mov_b32 s51, 0x20000
    s_mov_b32 s46, 1024
    s_mov_b32 s47, 0x20000
    v_and_b32 v4, 31, v2
    v_lshlrev_b32 v4, 5, v4
    v_lshrrev_b32 v5, 5, v2
    v_lshl_add_u32 v3, v5, 10, v4
    s_lshr_b32 s8, s6, 1
    s_lshl_b32 s8, s8, 11
    s_waitcnt lgkmcnt(0)
    buffer_load_dwordx4 v[16:19], v3, s[48:51], s8 offen
    buffer_load_dwordx4 v[20:23], v3, s[48:51], s8 offen offset:16
    buffer_load_dwordx4 v[24:27], v4, s[44:47], 0 offen
    buffer_load_dwordx4 v[28:31], v4, s[44:47], 0 offen offset:16
    s_barrier
    s_waitcnt vmcnt(0)
    v_mov_b32 v44, 0
    v_mov_b32 v43, 0
    s_mov_b32 s22, 0xffff0000
    v_lshlrev_b32 v32, 16, v16
    v_and_b32 v33, s22, v16
    v_lshlrev_b32 v34, 16, v24
    v_and_b32 v35, s22, v24
    v_mul_f32 v32, v32, v34
    v_mul_f32 v33, v33, v35
    v_cvt_pk_bf16_f32 v36, v32, v33
    v_lshlrev_b32 v37, 16, v36
    v_and_b32 v38, s22, v36
    v_add_f32 v44, v44, v37
    v_add_f32 v43, v43, v38
    v_lshlrev_b32 v32, 16, v17
    v_and_b32 v33, s22, v17
    v_lshlrev_b32 v34, 16, v25
    v_and_b32 v35, s22, v25
    v_mul_f32 v32, v32, v34
    v_mul_f32 v33, v33, v35
    v_cvt_pk_bf16_f32 v36, v32, v33
    v_lshlrev_b32 v37, 16, v36
    v_and_b32 v38, s22, v36
    v_add_f32 v44, v44, v37
    v_add_f32 v43, v43, v38
    v_lshlrev_b32 v32, 16, v18
    v_and_b32 v33, s22, v18
    v_lshlrev_b32 v34, 16, v26
    v_and_b32 v35, s22, v26
    v_mul_f32 v32, v32, v34
    v_mul_f32 v33, v33, v35
    v_cvt_pk_bf16_f32 v36, v32, v33
    v_lshlrev_b32 v37, 16, v36
    v_and_b32 v38, s22, v36
    v_add_f32 v44, v44, v37
    v_add_f32 v43, v43, v38
    v_lshlrev_b32 v32, 16, v19
    v_and_b32 v33, s22, v19
    v_lshlrev_b32 v34, 16, v27
    v_and_b32 v35, s22, v27
    v_mul_f32 v32, v32, v34
    v_mul_f32 v33, v33, v35
    v_cvt_pk_bf16_f32 v36, v32, v33
    v_lshlrev_b32 v37, 16, v36
    v_and_b32 v38, s22, v36
    v_add_f32 v44, v44, v37
    v_add_f32 v43, v43, v38
    v_lshlrev_b32 v32, 16, v20
    v_and_b32 v33, s22, v20
    v_lshlrev_b32 v34, 16, v28
    v_and_b32 v35, s22, v28
    v_mul_f32 v32, v32, v34
    v_mul_f32 v33, v33, v35
    v_cvt_pk_bf16_f32 v36, v32, v33
    v_lshlrev_b32 v37, 16, v36
    v_and_b32 v38, s22, v36
    v_add_f32 v44, v44, v37
    v_add_f32 v43, v43, v38
    v_lshlrev_b32 v32, 16, v21
    v_and_b32 v33, s22, v21
    v_lshlrev_b32 v34, 16, v29
    v_and_b32 v35, s22, v29
    v_mul_f32 v32, v32, v34
    v_mul_f32 v33, v33, v35
    v_cvt_pk_bf16_f32 v36, v32, v33
    v_lshlrev_b32 v37, 16, v36
    v_and_b32 v38, s22, v36
    v_add_f32 v44, v44, v37
    v_add_f32 v43, v43, v38
    v_lshlrev_b32 v32, 16, v22
    v_and_b32 v33, s22, v22
    v_lshlrev_b32 v34, 16, v30
    v_and_b32 v35, s22, v30
    v_mul_f32 v32, v32, v34
    v_mul_f32 v33, v33, v35
    v_cvt_pk_bf16_f32 v36, v32, v33
    v_lshlrev_b32 v37, 16, v36
    v_and_b32 v38, s22, v36
    v_add_f32 v44, v44, v37
    v_add_f32 v43, v43, v38
    v_lshlrev_b32 v32, 16, v23
    v_and_b32 v33, s22, v23
    v_lshlrev_b32 v34, 16, v31
    v_and_b32 v35, s22, v31
    v_mul_f32 v32, v32, v34
    v_mul_f32 v33, v33, v35
    v_cvt_pk_bf16_f32 v36, v32, v33
    v_lshlrev_b32 v37, 16, v36
    v_and_b32 v38, s22, v36
    v_add_f32 v44, v44, v37
    v_add_f32 v43, v43, v38
    v_add_f32 v44, v44, v43
    s_nop 1
    v_add_f32_dpp v45, v44, v44 row_ror:1 row_mask:0xf bank_mask:0xf
    v_mov_b32 v44, v45
    s_nop 1
    v_add_f32_dpp v45, v44, v44 row_ror:2 row_mask:0xf bank_mask:0xf
    v_mov_b32 v44, v45
    s_nop 1
    v_add_f32_dpp v45, v44, v44 row_ror:4 row_mask:0xf bank_mask:0xf
    v_mov_b32 v44, v45
    s_nop 1
    v_add_f32_dpp v45, v44, v44 row_ror:8 row_mask:0xf bank_mask:0xf
    v_mov_b32 v44, v45
    v_mov_b32 v45, v44
    s_nop 1
    v_permlane16_swap_b32 v44, v45
    v_add_f32 v44, v44, v45
    v_cvt_pk_bf16_f32 v44, v44, v44
    v_lshlrev_b32 v44, 16, v44
    v_mul_f32 v45, 0xbfb8aa3b, v44
    v_exp_f32 v45, v45
    s_nop 0
    v_add_f32 v45, 1.0, v45
    v_rcp_f32 v45, v45
    s_nop 0
    v_cvt_pk_bf16_f32 v45, v45, v45
    v_lshlrev_b32 v46, 16, v45
    v_sub_f32 v47, 1.0, v46
    v_cvt_pk_bf16_f32 v47, v47, v47
    v_lshlrev_b32 v47, 16, v47

    v_lshlrev_b32 v4, 3, v5
    ds_write_b64 v4, v[46:47] offset:1664
    v_mov_b32 v5, 36
    v_mov_b32 v6, 1
    ds_write_b32 v5, v6
L_V:
    s_setprio 1
    s_waitcnt lgkmcnt(0)
    s_mov_b32 s48, s40
    s_mov_b32 s49, s41
    s_mov_b32 s50, 67108864
    s_mov_b32 s51, 0x20000
    s_lshl_b32 s8, s6, 3
    s_add_u32 s8, s8, s4
    s_lshl_b32 s8, s8, 21
    s_add_u32 s8, s8, 0x180000
    s_lshl_b32 s9, s7, 16
    s_add_u32 s8, s8, s9
    s_lshl_b32 s9, s3, 14
    s_add_u32 s8, s8, s9
    v_and_b32 v3, 15, v2
    v_lshrrev_b32 v4, 4, v2
    v_lshlrev_b32 v6, 10, v4
    v_lshl_add_u32 v6, v3, 4, v6
    s_add_u32 s10, s7, 0
    s_and_b32 s10, s10, 3
    s_lshl_b32 s10, s10, 12
    s_add_u32 s10, s10, s8
    buffer_load_dwordx4 v[16:19], v6, s[48:51], s10 offen offset:0 nt
    buffer_load_dwordx4 v[20:23], v6, s[48:51], s10 offen offset:256 nt
    buffer_load_dwordx4 v[24:27], v6, s[48:51], s10 offen offset:512 nt
    buffer_load_dwordx4 v[28:31], v6, s[48:51], s10 offen offset:768 nt
    s_add_u32 s10, s7, 1
    s_and_b32 s10, s10, 3
    s_lshl_b32 s10, s10, 12
    s_add_u32 s10, s10, s8
    buffer_load_dwordx4 v[32:35], v6, s[48:51], s10 offen offset:0 nt
    buffer_load_dwordx4 v[36:39], v6, s[48:51], s10 offen offset:256 nt
    buffer_load_dwordx4 v[40:43], v6, s[48:51], s10 offen offset:512 nt
    buffer_load_dwordx4 v[44:47], v6, s[48:51], s10 offen offset:768 nt
    s_add_u32 s10, s7, 2
    s_and_b32 s10, s10, 3
    s_lshl_b32 s10, s10, 12
    s_add_u32 s10, s10, s8
    buffer_load_dwordx4 v[48:51], v6, s[48:51], s10 offen offset:0 nt
    buffer_load_dwordx4 v[52:55], v6, s[48:51], s10 offen offset:256 nt
    buffer_load_dwordx4 v[56:59], v6, s[48:51], s10 offen offset:512 nt
    buffer_load_dwordx4 v[60:63], v6, s[48:51], s10 offen offset:768 nt
    s_add_u32 s10, s7, 3
    s_and_b32 s10, s10, 3
    s_lshl_b32 s10, s10, 12
    s_add_u32 s10, s10, s8
    buffer_load_dwordx4 v[64:67], v6, s[48:51], s10 offen offset:0 nt
    buffer_load_dwordx4 v[68:71], v6, s[48:51], s10 offen offset:256 nt
    buffer_load_dwordx4 v[72:75], v6, s[48:51], s10 offen offset:512 nt
    buffer_load_dwordx4 v[76:79], v6, s[48:51], s10 offen offset:768 nt
    v_mov_b32 v14, 1
    s_setprio 2
    v_mov_b32 v10, 0
    s_mov_b32 s15, 0
Ltag_3:
    ds_read_b64 v[8:9], v10
    s_waitcnt lgkmcnt(0)
    v_readfirstlane_b32 s14, v9
    v_readfirstlane_b32 s64, v8
    s_add_u32 s15, s15, 1
    s_nop 1
    s_cmp_eq_u32 s14, 1
    s_cbranch_scc1 Ltagd_4
    s_cmp_lt_u32 s15, 16000000
    s_sleep 1
    s_cbranch_scc1 Ltag_3
Ltagd_4:
    s_lshl_b32 s16, s4, 1
    s_lshr_b32 s13, s6, 1
    s_add_u32 s16, s16, s13
    s_lshl_b32 s16, s16, 16
    s_and_b32 s13, s6, 1
    s_lshl_b32 s13, s13, 12
    s_add_u32 s16, s16, s13
    s_lshl_b32 s13, s7, 9
    s_add_u32 s16, s16, s13
    s_lshl_b32 s13, s3, 7
    s_add_u32 s16, s16, s13
    s_add_u32 s16, s16, 2097152
    s_lshl_b32 s9, s3, 11
    v_lshlrev_b32 v10, 4, v3
    v_add_u32 v10, s9, v10
    v_and_b32 v11, 3, v2
    v_lshlrev_b32 v11, 9, v11
    v_lshrrev_b32 v9, 2, v2
    v_lshl_add_u32 v11, v9, 4, v11
    s_lshl_b32 s9, s3, 2
    s_add_u32 s9, s9, 2048
    v_add_u32 v11, s9, v11
    v_lshrrev_b32 v12, 3, v2
    v_lshlrev_b32 v12, 13, v12
    v_and_b32 v9, 7, v2
    v_lshl_add_u32 v12, v9, 4, v12
    v_mov_b32 v153, s64
    v_mov_b32 v155, s64
    v_mov_b32 v13, 28
    s_lshl_b32 s9, s3, 2
    s_add_u32 s9, s9, 48
    v_mov_b32 v15, s9
    s_lshl_b32 s9, s3, 11
    v_lshlrev_b32 v5, 4, v2
    v_add_u32 v5, s9, v5
    s_lshl_b32 s9, s3, 4
    v_mov_b32 v7, s9
    s_waitcnt vmcnt(8)
    v_mov_b32 v8, 16
    s_mov_b64 exec, 1
    ds_add_u32 v8, v14
    s_mov_b64 exec, -1
    s_mov_b32 s15, 0
Lw_prdy_5:
    ds_read_b32 v8, v15
    s_waitcnt lgkmcnt(0)
    v_readfirstlane_b32 s14, v8
    s_add_u32 s15, s15, 1
    s_nop 2
    s_cmp_ge_u32 s14, 1
    s_cbranch_scc1 Lwd_prdy_6
    s_cmp_lt_u32 s15, 16000000
    s_sleep 1
    s_cbranch_scc1 Lw_prdy_5
Lwd_prdy_6:
    ds_read_b128 v[144:147], v5 offset:10240
    ds_read_b128 v[148:151], v5 offset:11264
    s_waitcnt vmcnt(8) lgkmcnt(0)
    v_perm_b32 v96, v20, v16, s66
    v_perm_b32 v97, v28, v24, s66
    v_perm_b32 v98, v36, v32, s66
    v_perm_b32 v99, v44, v40, s66
    v_perm_b32 v100, v20, v16, s67
    v_perm_b32 v101, v28, v24, s67
    v_perm_b32 v102, v36, v32, s67
    v_perm_b32 v103, v44, v40, s67
    v_mfma_f32_16x16x32_bf16 v[112:115], v[144:147], v[96:99], 0
    v_perm_b32 v104, v21, v17, s66
    v_perm_b32 v105, v29, v25, s66
    v_perm_b32 v106, v37, v33, s66
    v_perm_b32 v107, v45, v41, s66
    v_mfma_f32_16x16x32_bf16 v[116:119], v[144:147], v[100:103], 0
    v_perm_b32 v96, v21, v17, s67
    v_perm_b32 v97, v29, v25, s67
    v_perm_b32 v98, v37, v33, s67
    v_perm_b32 v99, v45, v41, s67
    v_mfma_f32_16x16x32_bf16 v[120:123], v[144:147], v[104:107], 0
    v_perm_b32 v100, v22, v18, s66
    v_perm_b32 v101, v30, v26, s66
    v_perm_b32 v102, v38, v34, s66
    v_perm_b32 v103, v46, v42, s66
    v_mfma_f32_16x16x32_bf16 v[124:127], v[144:147], v[96:99], 0
    v_perm_b32 v104, v22, v18, s67
    v_perm_b32 v105, v30, v26, s67
    v_perm_b32 v106, v38, v34, s67
    v_perm_b32 v107, v46, v42, s67
    v_mfma_f32_16x16x32_bf16 v[128:131], v[144:147], v[100:103], 0
    v_perm_b32 v96, v23, v19, s66
    v_perm_b32 v97, v31, v27, s66
    v_perm_b32 v98, v39, v35, s66
    v_perm_b32 v99, v47, v43, s66
    v_mfma_f32_16x16x32_bf16 v[132:135], v[144:147], v[104:107], 0
    v_perm_b32 v100, v23, v19, s67
    v_perm_b32 v101, v31, v27, s67
    v_perm_b32 v102, v39, v35, s67
    v_perm_b32 v103, v47, v43, s67
    v_mfma_f32_16x16x32_bf16 v[136:139], v[144:147], v[96:99], 0
    s_nop 0
    v_mfma_f32_16x16x32_bf16 v[140:143], v[144:147], v[100:103], 0
    v_mov_b32 v9, 24
    s_mov_b32 s15, 0
Lw_frdy_7:
    ds_read_b32 v8, v9
    s_waitcnt lgkmcnt(0)
    v_readfirstlane_b32 s14, v8
    s_add_u32 s15, s15, 1
    s_nop 2
    s_cmp_ge_u32 s14, 4
    s_cbranch_scc1 Lwd_frdy_8
    s_cmp_lt_u32 s15, 16000000
    s_cbranch_scc1 Lw_frdy_7
Lwd_frdy_8:
    ds_read_b128 v[156:159], v7 offset:1408
    s_waitcnt vmcnt(6)
    v_perm_b32 v16, v52, v48, s66
    v_perm_b32 v20, v52, v48, s67
    v_perm_b32 v24, v53, v49, s66
    v_perm_b32 v28, v53, v49, s67
    v_perm_b32 v32, v54, v50, s66
    v_perm_b32 v36, v54, v50, s67
    v_perm_b32 v40, v55, v51, s66
    v_perm_b32 v44, v55, v51, s67
    s_waitcnt vmcnt(4)
    v_perm_b32 v17, v60, v56, s66
    v_perm_b32 v21, v60, v56, s67
    v_perm_b32 v25, v61, v57, s66
    v_perm_b32 v29, v61, v57, s67
    v_perm_b32 v33, v62, v58, s66
    v_perm_b32 v37, v62, v58, s67
    v_perm_b32 v41, v63, v59, s66
    v_perm_b32 v45, v63, v59, s67
    s_waitcnt vmcnt(2)
    v_perm_b32 v18, v68, v64, s66
    v_perm_b32 v22, v68, v64, s67
    v_perm_b32 v26, v69, v65, s66
    v_perm_b32 v30, v69, v65, s67
    v_perm_b32 v34, v70, v66, s66
    v_perm_b32 v38, v70, v66, s67
    v_perm_b32 v42, v71, v67, s66
    v_perm_b32 v46, v71, v67, s67
    s_waitcnt vmcnt(0)
    v_perm_b32 v19, v76, v72, s66
    v_perm_b32 v23, v76, v72, s67
    v_perm_b32 v27, v77, v73, s66
    v_perm_b32 v31, v77, v73, s67
    v_perm_b32 v35, v78, v74, s66
    v_perm_b32 v39, v78, v74, s67
    v_perm_b32 v43, v79, v75, s66
    v_perm_b32 v47, v79, v75, s67
    v_mfma_f32_16x16x32_bf16 v[112:115], v[148:151], v[16:19], v[112:115]
    v_mfma_f32_16x16x32_bf16 v[116:119], v[148:151], v[20:23], v[116:119]
    v_mfma_f32_16x16x32_bf16 v[120:123], v[148:151], v[24:27], v[120:123]
    v_mfma_f32_16x16x32_bf16 v[124:127], v[148:151], v[28:31], v[124:127]
    v_mfma_f32_16x16x32_bf16 v[128:131], v[148:151], v[32:35], v[128:131]
    v_mfma_f32_16x16x32_bf16 v[132:135], v[148:151], v[36:39], v[132:135]
    v_mfma_f32_16x16x32_bf16 v[136:139], v[148:151], v[40:43], v[136:139]
    v_mfma_f32_16x16x32_bf16 v[140:143], v[148:151], v[44:47], v[140:143]
    s_mov_b64 exec, 0xffff
    ds_write_b128 v10, v[112:115] offset:2048
    ds_write_b128 v10, v[116:119] offset:2304
    ds_write_b128 v10, v[120:123] offset:2560
    ds_write_b128 v10, v[124:127] offset:2816
    ds_write_b128 v10, v[128:131] offset:3072
    ds_write_b128 v10, v[132:135] offset:3328
    ds_write_b128 v10, v[136:139] offset:3584
    ds_write_b128 v10, v[140:143] offset:3840
    ds_add_u32 v13, v14
    s_mov_b64 exec, -1
    v_mov_b32 v9, 28
    s_mov_b32 s15, 0
Lw_owc_9:
    ds_read_b32 v8, v9
    s_waitcnt lgkmcnt(0)
    v_readfirstlane_b32 s14, v8
    s_add_u32 s15, s15, 1
    s_nop 2
    s_cmp_ge_u32 s14, 64
    s_cbranch_scc1 Lwd_owc_10
    s_cmp_lt_u32 s15, 16000000
    s_cbranch_scc1 Lw_owc_9
Lwd_owc_10:
    ds_read2st64_b32 v[16:17], v11 offset0:0 offset1:1
    ds_read2st64_b32 v[18:19], v11 offset0:8 offset1:9
    ds_read2st64_b32 v[20:21], v11 offset0:16 offset1:17
    ds_read2st64_b32 v[22:23], v11 offset0:24 offset1:25
    s_waitcnt lgkmcnt(0)
    v_mul_f32 v152, v16, v156
    v_mul_f32 v154, v17, v156
    v_fmac_f32 v152, v18, v157
    v_fmac_f32 v154, v19, v157
    v_fmac_f32 v152, v20, v158
    v_fmac_f32 v154, v21, v158
    v_fmac_f32 v152, v22, v159
    v_fmac_f32 v154, v23, v159
    s_add_u32 s29, s16, 5242880
    v_mov_b32 v8, 40
    buffer_store_dwordx4 v[152:155], v12, s[52:55], s29 offen
    s_mov_b64 exec, 1
    ds_add_u32 v8, v14
    s_mov_b64 exec, -1
    buffer_store_dwordx4 v[152:155], v12, s[52:55], s16 offen sc1
    s_nop 0
    s_branch L_stamp
L_O:
    s_load_dwordx2 s[56:57], s[0:1], 32
    s_load_dwordx2 s[60:61], s[0:1], 64
    s_sub_u32 s3, s3, 8
    s_mov_b32 s58, 4194304
    s_mov_b32 s59, 0x20000
    s_mov_b32 s62, 1835008
    s_mov_b32 s63, 0x20000
    v_lshrrev_b32 v4, 4, v2
    v_bfe_u32 v3, v2, 3, 1
    v_and_b32 v8, 7, v2
    v_lshlrev_b32 v8, 4, v8
    v_lshlrev_b32 v5, 17, v4
    v_lshl_add_u32 v5, v3, 13, v5
    v_add_u32 v5, v5, v8
    v_lshrrev_b32 v6, 3, v2
    v_lshlrev_b32 v6, 12, v6
    v_add_u32 v6, v6, v8
    s_and_b32 s8, s6, 1
    s_lshl_b32 s10, s8, 9
    s_lshl_b32 s9, s3, 7
    s_add_u32 s10, s10, s9
    s_lshl_b32 s9, s4, 19
    s_lshl_b32 s11, s7, 14
    s_add_u32 s9, s9, s11
    s_add_u32 s9, s9, s10
    s_mul_i32 s11, s18, 28672
    s_add_u32 s11, s11, s10
    s_lshr_b32 s17, s6, 1
    s_lshl_b32 s17, s17, 7
    s_lshl_b32 s13, s8, 5
    s_add_u32 s17, s17, s13
    s_lshl_b32 s13, s3, 3
    s_add_u32 s17, s17, s13
    s_lshl_b32 s17, s17, 12
    s_lshl_b32 s13, s18, 6
    s_add_u32 s17, s17, s13
    s_add_u32 s17, s17, 4194304
    v_bfe_u32 v9, v2, 2, 1
    v_and_b32 v11, 1, v2
    v_lshl_add_u32 v11, v4, 1, v11
    v_lshlrev_b32 v7, 7, v9
    v_lshl_add_u32 v7, v11, 4, v7
    v_lshlrev_b32 v12, 6, v9
    v_lshl_add_u32 v15, v11, 3, v12
    v_cmp_eq_u32 s[20:21], 1, v3
    v_cmp_le_u32 s[22:23], 32, v2
    s_barrier

    v_mov_b32 v9, 16
    s_mov_b32 s15, 0
Lw_viss_11:
    ds_read_b32 v8, v9
    s_waitcnt lgkmcnt(0)
    v_readfirstlane_b32 s14, v8
    s_add_u32 s15, s15, 1
    s_nop 2
    s_cmp_ge_u32 s14, 4
    s_cbranch_scc1 Lwd_viss_12
    s_cmp_lt_u32 s15, 16000000
    s_sleep 2
    s_cbranch_scc1 Lw_viss_11
Lwd_viss_12:
    buffer_load_dwordx4 v[16:19], v6, s[60:63], s11 offen offset:0
    buffer_load_dwordx4 v[20:23], v6, s[60:63], s11 offen offset:1024
    buffer_load_dwordx4 v[24:27], v6, s[60:63], s11 offen offset:2048
    buffer_load_dwordx4 v[28:31], v6, s[60:63], s11 offen offset:3072
    s_add_u32 s12, s9, 4096
    buffer_load_dwordx4 v[32:35], v5, s[56:59], s9 offen offset:0
    buffer_load_dwordx4 v[36:39], v5, s[56:59], s9 offen offset:1024
    s_waitcnt vmcnt(5)
    buffer_load_dwordx4 v[40:43], v5, s[56:59], s9 offen offset:2048
    s_waitcnt vmcnt(5)
    buffer_load_dwordx4 v[44:47], v5, s[56:59], s9 offen offset:3072
    s_waitcnt vmcnt(5)
    buffer_load_dwordx4 v[48:51], v5, s[56:59], s12 offen offset:0
    s_waitcnt vmcnt(5)
    buffer_load_dwordx4 v[52:55], v5, s[56:59], s12 offen offset:1024
    s_waitcnt vmcnt(5)
    buffer_load_dwordx4 v[56:59], v5, s[56:59], s12 offen offset:2048
    s_waitcnt vmcnt(5)
    buffer_load_dwordx4 v[60:63], v5, s[56:59], s12 offen offset:3072
    s_setprio 2
    v_mov_b32 v10, 0
    s_mov_b32 s15, 0
Ltag_13:
    ds_read_b64 v[8:9], v10
    s_waitcnt lgkmcnt(0)
    v_readfirstlane_b32 s14, v9
    v_readfirstlane_b32 s64, v8
    s_add_u32 s15, s15, 1
    s_nop 1
    s_cmp_eq_u32 s14, 1
    s_cbranch_scc1 Ltagd_14
    s_cmp_lt_u32 s15, 16000000
    s_sleep 1
    s_cbranch_scc1 Ltag_13
Ltagd_14:
    v_bfe_u32 v8, v2, 4, 1
    v_lshlrev_b32 v10, 18, v8
    v_lshrrev_b32 v9, 5, v2
    v_lshl_add_u32 v10, v9, 14, v10
    v_bfe_u32 v9, v2, 3, 1
    v_lshl_add_u32 v10, v9, 13, v10
    v_bfe_u32 v9, v2, 2, 1
    v_lshl_add_u32 v10, v9, 12, v10
    v_and_b32 v9, 3, v2
    v_lshl_add_u32 v10, v9, 4, v10
    v_lshlrev_b32 v11, 3, v8
    v_mov_b32 v161, s64
    v_mov_b32 v163, s64
    v_mov_b32 v9, 12
    s_mov_b32 s15, 0
Lw_hrdy_15:
    ds_read_b32 v8, v9
    s_waitcnt lgkmcnt(0)
    v_readfirstlane_b32 s14, v8
    s_add_u32 s15, s15, 1
    s_nop 2
    s_cmp_ge_u32 s14, 1
    s_cbranch_scc1 Lwd_hrdy_16
    s_cmp_lt_u32 s15, 16000000
    s_sleep 1
    s_cbranch_scc1 Lw_hrdy_15
Lwd_hrdy_16:
    ds_read_b64 v[144:145], v15 offset:1536
    v_mov_b32 v9, 36
    s_mov_b32 s15, 0
Lw_grdy_17:
    ds_read_b32 v8, v9
    s_waitcnt lgkmcnt(0)
    v_readfirstlane_b32 s14, v8
    s_add_u32 s15, s15, 1
    s_nop 2
    s_cmp_ge_u32 s14, 1
    s_cbranch_scc1 Lwd_grdy_18
    s_cmp_lt_u32 s15, 16000000
    s_sleep 1
    s_cbranch_scc1 Lw_grdy_17
Lwd_grdy_18:
    ds_read_b64 v[12:13], v11 offset:1664
    s_waitcnt lgkmcnt(0)
    s_waitcnt vmcnt(8)
    v_perm_b32 v64, v20, v16, s66
    v_perm_b32 v65, v28, v24, s66
    v_perm_b32 v66, v20, v16, s67
    v_perm_b32 v67, v28, v24, s67
    v_perm_b32 v68, v21, v17, s66
    v_perm_b32 v69, v29, v25, s66
    v_perm_b32 v70, v21, v17, s67
    v_perm_b32 v71, v29, v25, s67
    v_perm_b32 v72, v22, v18, s66
    v_perm_b32 v73, v30, v26, s66
    v_perm_b32 v74, v22, v18, s67
    v_perm_b32 v75, v30, v26, s67
    v_perm_b32 v76, v23, v19, s66
    v_perm_b32 v77, v31, v27, s66
    v_perm_b32 v78, v23, v19, s67
    v_perm_b32 v79, v31, v27, s67
    v_mfma_f32_16x16x16_bf16 v[112:115], v[144:145], v[64:65], 0
    v_mfma_f32_16x16x16_bf16 v[116:119], v[144:145], v[66:67], 0
    v_mfma_f32_16x16x16_bf16 v[120:123], v[144:145], v[68:69], 0
    v_mfma_f32_16x16x16_bf16 v[124:127], v[144:145], v[70:71], 0
    v_mfma_f32_16x16x16_bf16 v[128:131], v[144:145], v[72:73], 0
    v_mfma_f32_16x16x16_bf16 v[132:135], v[144:145], v[74:75], 0
    v_mfma_f32_16x16x16_bf16 v[136:139], v[144:145], v[76:77], 0
    v_mfma_f32_16x16x16_bf16 v[140:143], v[144:145], v[78:79], 0
    s_waitcnt vmcnt(0)
    v_perm_b32 v80, v36, v32, s66
    v_perm_b32 v81, v44, v40, s66
    v_perm_b32 v82, v52, v48, s66
    v_perm_b32 v83, v60, v56, s66
    v_perm_b32 v84, v36, v32, s67
    v_perm_b32 v85, v44, v40, s67
    v_perm_b32 v86, v52, v48, s67
    v_perm_b32 v87, v60, v56, s67
    v_perm_b32 v88, v37, v33, s66
    v_perm_b32 v89, v45, v41, s66
    v_perm_b32 v90, v53, v49, s66
    v_perm_b32 v91, v61, v57, s66
    v_perm_b32 v92, v37, v33, s67
    v_perm_b32 v93, v45, v41, s67
    v_perm_b32 v94, v53, v49, s67
    v_perm_b32 v95, v61, v57, s67
    v_perm_b32 v96, v38, v34, s66
    v_perm_b32 v97, v46, v42, s66
    v_perm_b32 v98, v54, v50, s66
    v_perm_b32 v99, v62, v58, s66
    v_perm_b32 v100, v38, v34, s67
    v_perm_b32 v101, v46, v42, s67
    v_perm_b32 v102, v54, v50, s67
    v_perm_b32 v103, v62, v58, s67
    v_perm_b32 v104, v39, v35, s66
    v_perm_b32 v105, v47, v43, s66
    v_perm_b32 v106, v55, v51, s66
    v_perm_b32 v107, v63, v59, s66
    v_perm_b32 v108, v39, v35, s67
    v_perm_b32 v109, v47, v43, s67
    v_perm_b32 v110, v55, v51, s67
    v_perm_b32 v111, v63, v59, s67
    v_cndmask_b32 v152, v112, v129, s[20:21]
    v_cndmask_b32 v156, v128, v113, s[20:21]
    v_cndmask_b32 v153, v116, v133, s[20:21]
    v_cndmask_b32 v157, v132, v117, s[20:21]
    v_cndmask_b32 v154, v120, v137, s[20:21]
    v_cndmask_b32 v158, v136, v121, s[20:21]
    v_cndmask_b32 v155, v124, v141, s[20:21]
    v_cndmask_b32 v159, v140, v125, s[20:21]
    v_cndmask_b32 v152, v152, v154, s[22:23]
    v_cndmask_b32 v153, v153, v155, s[22:23]
    v_cndmask_b32 v156, v156, v158, s[22:23]
    v_cndmask_b32 v157, v157, v159, s[22:23]
    s_nop 0
    v_add_f32_dpp v14, v156, v152 row_ror:8 row_mask:0xf bank_mask:0xf
    v_add_f32_dpp v15, v157, v153 row_ror:8 row_mask:0xf bank_mask:0xf
    v_mul_f32 v14, v14, v13
    v_mul_f32 v15, v15, v13
    v_mov_b32 v11, 40
    v_mov_b32 v6, 1
    v_mov_b32 v9, 32
    s_mov_b32 s15, 0
Lw_ocr_19:
    ds_read_b32 v8, v9
    s_waitcnt lgkmcnt(0)
    v_readfirstlane_b32 s14, v8
    s_add_u32 s15, s15, 1
    s_nop 2
    s_cmp_ge_u32 s14, 2
    s_cbranch_scc1 Lwd_ocr_20
    s_cmp_lt_u32 s15, 16000000
    s_cbranch_scc1 Lw_ocr_19
Lwd_ocr_20:
    ds_read_b128 v[148:151], v7 offset:1792
    s_waitcnt lgkmcnt(0)
    v_mfma_f32_16x16x32_bf16 v[112:115], v[148:151], v[80:83], 0
    v_mfma_f32_16x16x32_bf16 v[116:119], v[148:151], v[84:87], 0
    v_mfma_f32_16x16x32_bf16 v[120:123], v[148:151], v[88:91], 0
    v_mfma_f32_16x16x32_bf16 v[124:127], v[148:151], v[92:95], 0
    v_mfma_f32_16x16x32_bf16 v[128:131], v[148:151], v[96:99], 0
    v_mfma_f32_16x16x32_bf16 v[132:135], v[148:151], v[100:103], 0
    v_mfma_f32_16x16x32_bf16 v[136:139], v[148:151], v[104:107], 0
    v_mfma_f32_16x16x32_bf16 v[140:143], v[148:151], v[108:111], 0
    s_nop 4
    v_cndmask_b32 v152, v112, v129, s[20:21]
    v_cndmask_b32 v156, v128, v113, s[20:21]
    v_cndmask_b32 v153, v116, v133, s[20:21]
    v_cndmask_b32 v157, v132, v117, s[20:21]
    v_cndmask_b32 v154, v120, v137, s[20:21]
    v_cndmask_b32 v158, v136, v121, s[20:21]
    v_cndmask_b32 v155, v124, v141, s[20:21]
    v_cndmask_b32 v159, v140, v125, s[20:21]
    v_cndmask_b32 v152, v152, v154, s[22:23]
    v_cndmask_b32 v153, v153, v155, s[22:23]
    v_cndmask_b32 v156, v156, v158, s[22:23]
    v_cndmask_b32 v157, v157, v159, s[22:23]
    s_nop 0
    v_add_f32_dpp v160, v156, v152 row_ror:8 row_mask:0xf bank_mask:0xf
    v_add_f32_dpp v162, v157, v153 row_ror:8 row_mask:0xf bank_mask:0xf
    v_fma_f32 v160, v160, v12, v14
    v_fma_f32 v162, v162, v12, v15
    buffer_store_dwordx4 v[160:163], v10, s[52:55], s17 offen sc1
    s_waitcnt vmcnt(0)

    s_mov_b64 exec, 1
    ds_add_u32 v11, v6
    s_mov_b64 exec, -1
    s_branch L_stamp
L_K:
    s_load_dwordx2 s[44:45], s[0:1], 8
    s_setprio 2
    s_mov_b32 s46, 67108864
    s_mov_b32 s47, 0x20000
    s_lshl_b32 s8, s6, 3
    s_add_u32 s8, s8, s4
    s_lshl_b32 s17, s8, 9
    s_lshl_b32 s8, s8, 21
    s_add_u32 s8, s8, 0x180000
    s_lshl_b32 s9, s7, 16
    s_add_u32 s8, s8, s9
    s_lshl_b32 s9, s3, 14
    s_add_u32 s8, s8, s9
    s_lshl_b32 s13, s7, 6
    s_add_u32 s17, s17, s13
    s_lshl_b32 s13, s3, 4
    s_add_u32 s17, s17, s13
    s_add_u32 s17, s17, 1572864
    s_lshl_b32 s12, s4, 2
    s_add_u32 s12, s12, s6
    s_lshl_b32 s12, s12, 14
    s_lshl_b32 s13, s3, 10
    s_add_u32 s12, s12, s13
    s_add_u32 s12, s12, 65536
    s_mov_b32 s27, 5242880
    v_and_b32 v3, 15, v2
    v_lshrrev_b32 v4, 4, v2
    v_lshlrev_b32 v5, 8, v3
    v_lshl_add_u32 v5, v4, 4, v5
    v_lshlrev_b32 v7, 4, v2
    s_waitcnt lgkmcnt(0)
    s_barrier
    s_add_u32 s10, s7, 0
    s_and_b32 s10, s10, 3
    s_lshl_b32 s10, s10, 12
    s_add_u32 s10, s10, s8
    buffer_load_dwordx4 v[16:19], v5, s[44:47], s10 offen offset:0 nt
    buffer_load_dwordx4 v[20:23], v5, s[44:47], s10 offen offset:64 nt
    buffer_load_dwordx4 v[24:27], v5, s[44:47], s10 offen offset:128 nt
    buffer_load_dwordx4 v[28:31], v5, s[44:47], s10 offen offset:192 nt
    s_add_u32 s10, s7, 1
    s_and_b32 s10, s10, 3
    s_lshl_b32 s10, s10, 12
    s_add_u32 s10, s10, s8
    buffer_load_dwordx4 v[32:35], v5, s[44:47], s10 offen offset:0 nt
    buffer_load_dwordx4 v[36:39], v5, s[44:47], s10 offen offset:64 nt
    buffer_load_dwordx4 v[40:43], v5, s[44:47], s10 offen offset:128 nt
    buffer_load_dwordx4 v[44:47], v5, s[44:47], s10 offen offset:192 nt
    s_add_u32 s10, s7, 2
    s_and_b32 s10, s10, 3
    s_lshl_b32 s10, s10, 12
    s_add_u32 s10, s10, s8
    buffer_load_dwordx4 v[48:51], v5, s[44:47], s10 offen offset:0 nt
    buffer_load_dwordx4 v[52:55], v5, s[44:47], s10 offen offset:64 nt
    buffer_load_dwordx4 v[56:59], v5, s[44:47], s10 offen offset:128 nt
    buffer_load_dwordx4 v[60:63], v5, s[44:47], s10 offen offset:192 nt
    s_add_u32 s10, s7, 3
    s_and_b32 s10, s10, 3
    s_lshl_b32 s10, s10, 12
    s_add_u32 s10, s10, s8
    buffer_load_dwordx4 v[64:67], v5, s[44:47], s10 offen offset:0 nt
    buffer_load_dwordx4 v[68:71], v5, s[44:47], s10 offen offset:64 nt
    buffer_load_dwordx4 v[72:75], v5, s[44:47], s10 offen offset:128 nt
    buffer_load_dwordx4 v[76:79], v5, s[44:47], s10 offen offset:192 nt
    v_mov_b32 v10, 0
    s_mov_b32 s15, 0
Ltag_21:
    ds_read_b64 v[8:9], v10
    s_waitcnt lgkmcnt(0)
    v_readfirstlane_b32 s14, v9
    v_readfirstlane_b32 s64, v8
    s_add_u32 s15, s15, 1
    s_nop 1
    s_cmp_eq_u32 s14, 1
    s_cbranch_scc1 Ltagd_22
    s_cmp_lt_u32 s15, 16000000
    s_sleep 1
    s_cbranch_scc1 Ltag_21
Ltagd_22:
    v_lshrrev_b32 v10, 5, v2
    v_lshlrev_b32 v10, 7, v10
    v_and_b32 v11, 7, v2
    v_lshl_add_u32 v10, v11, 4, v10
    v_bfe_u32 v11, v2, 3, 1
    v_lshl_add_u32 v10, v11, 3, v10
    v_bfe_u32 v11, v2, 4, 1
    v_lshl_add_u32 v10, v11, 2, v10
    s_lshl_b32 s9, s3, 8
    v_add_u32 v10, s9, v10
    v_and_b32 v8, 3, v2
    v_lshlrev_b32 v9, 8, v8
    v_lshl_add_u32 v15, v4, 4, v9
    v_mov_b32 v14, 1
    s_lshl_b32 s9, s3, 11
    v_add_u32 v6, s9, v7
    s_lshl_b32 s9, s3, 5
    v_lshl_add_u32 v12, v8, 3, s9
    s_lshl_b32 s9, s3, 2
    s_add_u32 s9, s9, 48
    v_mov_b32 v11, s9
    s_waitcnt vmcnt(8)
    s_add_u32 s28, s12, s27
    s_add_u32 s13, s28, 0
    buffer_load_dwordx4 v[112:115], v7, s[52:55], s13 offen sc1
    s_add_u32 s13, s28, 4096
    buffer_load_dwordx4 v[116:119], v7, s[52:55], s13 offen sc1
    s_add_u32 s13, s28, 8192
    buffer_load_dwordx4 v[120:123], v7, s[52:55], s13 offen sc1
    s_add_u32 s13, s28, 12288
    buffer_load_dwordx4 v[124:127], v7, s[52:55], s13 offen sc1
    s_mov_b32 s15, 0
    s_waitcnt vmcnt(0)
    s_branch Lpc_q_25
Lp_q_23:
    s_and_b32 s14, s15, 1
    s_cmp_eq_u32 s14, 1
    s_cselect_b32 s27, 0, 5242880
    s_add_u32 s28, s12, s27
    s_add_u32 s13, s28, 0
    buffer_load_dwordx4 v[112:115], v7, s[52:55], s13 offen sc1
    s_add_u32 s13, s28, 4096
    buffer_load_dwordx4 v[116:119], v7, s[52:55], s13 offen sc1
    s_add_u32 s13, s28, 8192
    buffer_load_dwordx4 v[120:123], v7, s[52:55], s13 offen sc1
    s_add_u32 s13, s28, 12288
    buffer_load_dwordx4 v[124:127], v7, s[52:55], s13 offen sc1
    s_waitcnt vmcnt(0)
Lpc_q_25:
    v_min_u32 v8, v113, v115
    v_max_u32 v9, v113, v115
    v_min3_u32 v8, v8, v117, v119
    v_max3_u32 v9, v9, v117, v119
    v_min3_u32 v8, v8, v121, v123
    v_max3_u32 v9, v9, v121, v123
    v_min3_u32 v8, v8, v125, v127
    v_max3_u32 v9, v9, v125, v127
    v_xor_b32 v8, s64, v8
    v_xor_b32 v9, s64, v9
    v_or_b32 v8, v8, v9
    v_cmp_ne_u32 vcc, 0, v8
    s_add_u32 s15, s15, 1
    s_nop 2
    s_cbranch_vccz Lpd_q_24
    s_cmp_lt_u32 s15, 1000000
    s_sleep 1
    s_cbranch_scc1 Lp_q_23
Lpd_q_24:
    s_mov_b32 s96, s15
    s_mov_b32 s31, s27
    s_mul_i32 s8, s18, 28
    v_and_b32 v152, 15, v2
    v_min_u32 v152, 13, v152
    v_lshl_add_u32 v152, v152, 1, s8
    v_lshrrev_b32 v153, 6, v152
    v_lshlrev_b32 v153, 9, v153
    v_bfe_u32 v154, v152, 1, 1
    v_lshl_add_u32 v153, v154, 8, v153
    v_bfe_u32 v154, v152, 2, 1
    v_lshl_add_u32 v153, v154, 7, v153
    v_bfe_u32 v154, v152, 3, 3
    v_lshl_add_u32 v153, v154, 4, v153
    v_lshrrev_b32 v154, 5, v2
    s_mov_b32 s8, 229376
    v_mul_lo_u32 v154, v154, s8
    v_add_u32 v153, v153, v154
    v_bfe_u32 v154, v2, 4, 1
    s_movk_i32 s8, 14336
    v_mul_lo_u32 v154, v154, s8
    v_add_u32 v153, v153, v154
    s_and_b32 s19, s6, 2
    s_mul_i32 s19, s19, 14336
    s_add_u32 s19, s19, 1048576

    s_cmp_eq_u32 s3, 1
    s_cbranch_scc0 L_nohl
    s_add_u32 s8, s19, 0
    buffer_load_dwordx4 v[136:139], v153, s[52:55], s8 offen sc1
    s_add_u32 s8, s19, 57344
    buffer_load_dwordx4 v[140:143], v153, s[52:55], s8 offen sc1
    s_add_u32 s8, s19, 114688
    buffer_load_dwordx4 v[144:147], v153, s[52:55], s8 offen sc1
    s_add_u32 s8, s19, 172032
    buffer_load_dwordx4 v[148:151], v153, s[52:55], s8 offen sc1
L_nohl:
    v_add_f32 v112, v112, v116
    v_add_f32 v120, v120, v124
    v_add_f32 v114, v114, v118
    v_add_f32 v122, v122, v126
    v_add_f32 v112, v112, v120
    v_add_f32 v114, v114, v122
    v_cvt_pk_bf16_f32 v8, v112, v114
    v_mov_b32 v13, 8
    ds_write_b32 v10, v8 offset:256
    ds_add_u32 v13, v14
    v_mov_b32 v9, 8
    s_mov_b32 s15, 0
Lw_qrdy_26:
    ds_read_b32 v8, v9
    s_waitcnt lgkmcnt(0)
    v_readfirstlane_b32 s14, v8
    s_add_u32 s15, s15, 1
    s_nop 2
    s_cmp_ge_u32 s14, 256
    s_cbranch_scc1 Lwd_qrdy_27
    s_cmp_lt_u32 s15, 16000000
    s_cbranch_scc1 Lw_qrdy_26
Lwd_qrdy_27:
    ds_read_b128 v[80:83], v15 offset:256
    ds_read_b128 v[84:87], v15 offset:320
    ds_read_b128 v[88:91], v15 offset:384
    ds_read_b128 v[92:95], v15 offset:448
    s_waitcnt lgkmcnt(0)
    v_mfma_f32_16x16x32_bf16 v[96:99], v[16:19], v[80:83], 0
    v_mfma_f32_16x16x32_bf16 v[100:103], v[32:35], v[80:83], 0
    v_mfma_f32_16x16x32_bf16 v[104:107], v[48:51], v[80:83], 0
    v_mfma_f32_16x16x32_bf16 v[108:111], v[64:67], v[80:83], 0
    v_mfma_f32_16x16x32_bf16 v[96:99], v[20:23], v[84:87], v[96:99]
    v_mfma_f32_16x16x32_bf16 v[100:103], v[36:39], v[84:87], v[100:103]
    v_mfma_f32_16x16x32_bf16 v[104:107], v[52:55], v[84:87], v[104:107]
    v_mfma_f32_16x16x32_bf16 v[108:111], v[68:71], v[84:87], v[108:111]
    v_mfma_f32_16x16x32_bf16 v[96:99], v[24:27], v[88:91], v[96:99]
    v_mfma_f32_16x16x32_bf16 v[100:103], v[40:43], v[88:91], v[100:103]
    v_mfma_f32_16x16x32_bf16 v[104:107], v[56:59], v[88:91], v[104:107]
    v_mfma_f32_16x16x32_bf16 v[108:111], v[72:75], v[88:91], v[108:111]
    v_mfma_f32_16x16x32_bf16 v[96:99], v[28:31], v[92:95], v[96:99]
    v_mfma_f32_16x16x32_bf16 v[100:103], v[44:47], v[92:95], v[100:103]
    v_mfma_f32_16x16x32_bf16 v[104:107], v[60:63], v[92:95], v[104:107]
    v_mfma_f32_16x16x32_bf16 v[108:111], v[76:79], v[92:95], v[108:111]
    s_mov_b32 s24, 0x3db504f3
    s_mov_b32 s25, 0x3fb8aa3b
    s_mov_b32 s26, 0xffff0000
    s_nop 1
    v_cvt_pk_bf16_f32 v16, v96, v97
    v_cvt_pk_bf16_f32 v17, v98, v99
    v_cvt_pk_bf16_f32 v18, v100, v101
    v_cvt_pk_bf16_f32 v19, v102, v103
    v_cvt_pk_bf16_f32 v20, v104, v105
    v_cvt_pk_bf16_f32 v21, v106, v107
    v_cvt_pk_bf16_f32 v22, v108, v109
    v_cvt_pk_bf16_f32 v23, v110, v111
    v_lshlrev_b32 v96, 16, v16
    v_and_b32 v97, s26, v16
    v_lshlrev_b32 v98, 16, v17
    v_and_b32 v99, s26, v17
    v_lshlrev_b32 v100, 16, v18
    v_and_b32 v101, s26, v18
    v_lshlrev_b32 v102, 16, v19
    v_and_b32 v103, s26, v19
    v_lshlrev_b32 v104, 16, v20
    v_and_b32 v105, s26, v20
    v_lshlrev_b32 v106, 16, v21
    v_and_b32 v107, s26, v21
    v_lshlrev_b32 v108, 16, v22
    v_and_b32 v109, s26, v22
    v_lshlrev_b32 v110, 16, v23
    v_and_b32 v111, s26, v23
    v_mul_f32 v96, s24, v96
    v_mul_f32 v97, s24, v97
    v_mul_f32 v98, s24, v98
    v_mul_f32 v99, s24, v99
    v_mul_f32 v100, s24, v100
    v_mul_f32 v101, s24, v101
    v_mul_f32 v102, s24, v102
    v_mul_f32 v103, s24, v103
    v_mul_f32 v104, s24, v104
    v_mul_f32 v105, s24, v105
    v_mul_f32 v106, s24, v106
    v_mul_f32 v107, s24, v107
    v_mul_f32 v108, s24, v108
    v_mul_f32 v109, s24, v109
    v_mul_f32 v110, s24, v110
    v_mul_f32 v111, s24, v111
    v_cvt_pk_bf16_f32 v16, v96, v97
    v_cvt_pk_bf16_f32 v17, v98, v99
    v_cvt_pk_bf16_f32 v18, v100, v101
    v_cvt_pk_bf16_f32 v19, v102, v103
    v_cvt_pk_bf16_f32 v20, v104, v105
    v_cvt_pk_bf16_f32 v21, v106, v107
    v_cvt_pk_bf16_f32 v22, v108, v109
    v_cvt_pk_bf16_f32 v23, v110, v111
    v_lshlrev_b32 v96, 16, v16
    v_and_b32 v97, s26, v16
    v_lshlrev_b32 v98, 16, v17
    v_and_b32 v99, s26, v17
    v_lshlrev_b32 v100, 16, v18
    v_and_b32 v101, s26, v18
    v_lshlrev_b32 v102, 16, v19
    v_and_b32 v103, s26, v19
    v_lshlrev_b32 v104, 16, v20
    v_and_b32 v105, s26, v20
    v_lshlrev_b32 v106, 16, v21
    v_and_b32 v107, s26, v21
    v_lshlrev_b32 v108, 16, v22
    v_and_b32 v109, s26, v22
    v_lshlrev_b32 v110, 16, v23
    v_and_b32 v111, s26, v23
    v_max3_f32 v10, v96, v97, v98
    v_max3_f32 v9, v99, v100, v101
    v_max3_f32 v10, v10, v102, v103
    v_max3_f32 v9, v9, v104, v105
    v_max3_f32 v10, v10, v106, v107
    v_max3_f32 v9, v9, v108, v109
    v_max3_f32 v10, v10, v110, v111
    v_max_f32 v10, v10, v9
    v_mov_b32 v9, v10
    s_nop 1
    v_permlane16_swap_b32 v10, v9
    v_max_f32 v10, v10, v9
    v_mov_b32 v9, v10
    s_nop 1
    v_permlane32_swap_b32 v10, v9
    v_max_f32 v10, v10, v9
    v_mul_f32 v10, s25, v10
    v_fma_f32 v96, v96, s25, -v10
    v_fma_f32 v97, v97, s25, -v10
    v_fma_f32 v98, v98, s25, -v10
    v_fma_f32 v99, v99, s25, -v10
    v_fma_f32 v100, v100, s25, -v10
    v_fma_f32 v101, v101, s25, -v10
    v_fma_f32 v102, v102, s25, -v10
    v_fma_f32 v103, v103, s25, -v10
    v_fma_f32 v104, v104, s25, -v10
    v_fma_f32 v105, v105, s25, -v10
    v_fma_f32 v106, v106, s25, -v10
    v_fma_f32 v107, v107, s25, -v10
    v_fma_f32 v108, v108, s25, -v10
    v_fma_f32 v109, v109, s25, -v10
    v_fma_f32 v110, v110, s25, -v10
    v_fma_f32 v111, v111, s25, -v10
    v_exp_f32 v96, v96
    v_exp_f32 v97, v97
    v_exp_f32 v98, v98
    v_exp_f32 v99, v99
    v_exp_f32 v100, v100
    v_exp_f32 v101, v101
    v_exp_f32 v102, v102
    v_exp_f32 v103, v103
    v_exp_f32 v104, v104
    v_exp_f32 v105, v105
    v_exp_f32 v106, v106
    v_exp_f32 v107, v107
    v_exp_f32 v108, v108
    v_exp_f32 v109, v109
    v_exp_f32 v110, v110
    v_exp_f32 v111, v111
    v_cvt_pk_bf16_f32 v128, v96, v97
    v_cvt_pk_bf16_f32 v129, v98, v99
    v_cvt_pk_bf16_f32 v130, v100, v101
    v_cvt_pk_bf16_f32 v131, v102, v103
    v_cvt_pk_bf16_f32 v132, v104, v105
    v_cvt_pk_bf16_f32 v133, v106, v107
    v_cvt_pk_bf16_f32 v134, v108, v109
    v_cvt_pk_bf16_f32 v135, v110, v111
    ds_write_b128 v6, v[128:131] offset:10240
    ds_write_b128 v6, v[132:135] offset:11264
    ds_write_b32 v11, v14
    v_add_f32 v9, v96, v97
    v_add_f32 v8, v98, v99
    v_add_f32 v9, v9, v100
    v_add_f32 v8, v8, v101
    v_add_f32 v9, v9, v102
    v_add_f32 v8, v8, v103
    v_add_f32 v9, v9, v104
    v_add_f32 v8, v8, v105
    v_add_f32 v9, v9, v106
    v_add_f32 v8, v8, v107
    v_add_f32 v9, v9, v108
    v_add_f32 v8, v8, v109
    v_add_f32 v9, v9, v110
    v_add_f32 v8, v8, v111
    v_add_f32 v11, v9, v8
    v_mov_b32 v9, v11
    s_nop 1
    v_permlane16_swap_b32 v11, v9
    v_add_f32 v11, v11, v9
    v_mov_b32 v9, v11
    s_nop 1
    v_permlane32_swap_b32 v11, v9
    v_add_f32 v11, v11, v9
    v_mov_b32 v13, 20
    ds_write_b64 v12, v[10:11] offset:1280
    ds_add_u32 v13, v14
    v_mov_b32 v9, 20
    s_mov_b32 s15, 0
Lw_mlc_28:
    ds_read_b32 v8, v9
    s_waitcnt lgkmcnt(0)
    v_readfirstlane_b32 s14, v8
    s_add_u32 s15, s15, 1
    s_nop 2
    s_cmp_ge_u32 s14, 256
    s_cbranch_scc1 Lwd_mlc_29
    s_cmp_lt_u32 s15, 16000000
    s_cbranch_scc1 Lw_mlc_28
Lwd_mlc_29:
    s_lshl_b32 s9, s3, 3
    v_mov_b32 v8, s9
    ds_read_b64 v[16:17], v8 offset:1280
    ds_read_b64 v[18:19], v8 offset:1312
    ds_read_b64 v[20:21], v8 offset:1344
    ds_read_b64 v[22:23], v8 offset:1376
    s_waitcnt lgkmcnt(0)
    v_max_f32 v24, v16, v18
    v_max3_f32 v24, v24, v20, v22
    v_sub_f32 v28, v16, v24
    v_sub_f32 v29, v18, v24
    v_sub_f32 v30, v20, v24
    v_sub_f32 v31, v22, v24
    v_exp_f32 v28, v28
    v_exp_f32 v29, v29
    v_exp_f32 v30, v30
    v_exp_f32 v31, v31
    v_mov_b32 v25, s64
    v_mov_b32 v27, s64
    v_mul_f32 v26, v28, v17
    v_fmac_f32 v26, v29, v19
    v_fmac_f32 v26, v30, v21
    v_fmac_f32 v26, v31, v23
    s_lshl_b32 s9, s3, 4
    v_mov_b32 v8, s9
    v_mov_b32 v9, 24
    s_mov_b64 exec, 1
    ds_write_b128 v8, v[28:31] offset:1408
    ds_add_u32 v9, v14
    v_mov_b32 v8, 0
    s_add_u32 s29, s17, 5242880
    buffer_store_dwordx4 v[24:27], v8, s[52:55], s29 offen
    buffer_store_dwordx4 v[24:27], v8, s[52:55], s17 offen sc1
    s_mov_b64 exec, -1
    s_cmp_eq_u32 s3, 1
    s_cbranch_scc1 L_hg
    s_cmp_eq_u32 s3, 3
    s_cbranch_scc1 L_fin
    s_branch L_mo
L_hg:
    s_mov_b32 s15, 0
    s_waitcnt vmcnt(2)
    s_branch Lpc_h_32
Lp_h_30:
    s_add_u32 s8, s19, 0
    buffer_load_dwordx4 v[136:139], v153, s[52:55], s8 offen sc1
    s_add_u32 s8, s19, 57344
    buffer_load_dwordx4 v[140:143], v153, s[52:55], s8 offen sc1
    s_add_u32 s8, s19, 114688
    buffer_load_dwordx4 v[144:147], v153, s[52:55], s8 offen sc1
    s_add_u32 s8, s19, 172032
    buffer_load_dwordx4 v[148:151], v153, s[52:55], s8 offen sc1
    s_waitcnt vmcnt(0)
Lpc_h_32:
    v_min_u32 v8, v137, v139
    v_max_u32 v9, v137, v139
    v_min3_u32 v8, v8, v141, v143
    v_max3_u32 v9, v9, v141, v143
    v_min3_u32 v8, v8, v145, v147
    v_max3_u32 v9, v9, v145, v147
    v_min3_u32 v8, v8, v149, v151
    v_max3_u32 v9, v9, v149, v151
    v_xor_b32 v8, s64, v8
    v_xor_b32 v9, s64, v9
    v_or_b32 v8, v8, v9
    v_cmp_ne_u32 vcc, 0, v8
    s_add_u32 s15, s15, 1
    s_nop 2
    s_cbranch_vccz Lpd_h_31
    s_cmp_lt_u32 s15, 1000000
    s_sleep 2
    s_cbranch_scc1 Lp_h_30
Lpd_h_31:
    s_mov_b32 s96, s15
    v_add_f32 v136, v136, v140
    v_add_f32 v144, v144, v148
    v_add_f32 v138, v138, v142
    v_add_f32 v146, v146, v150
    v_add_f32 v136, v136, v144
    v_add_f32 v138, v138, v146
    v_cvt_pk_bf16_f32 v156, v136, v138
    v_mov_b32 v157, v156
    s_nop 1
    v_permlane32_swap_b32 v156, v157
    v_lshlrev_b32 v158, 16, v156
    v_and_b32 v159, 0xffff0000, v156
    v_lshlrev_b32 v160, 16, v157
    v_and_b32 v161, 0xffff0000, v157
    v_mul_f32 v162, 0xbfb8aa3b, v158
    v_mul_f32 v163, 0xbfb8aa3b, v159
    v_exp_f32 v162, v162
    v_exp_f32 v163, v163
    v_add_f32 v162, 1.0, v162
    v_add_f32 v163, 1.0, v163
    v_rcp_f32 v162, v162
    v_rcp_f32 v163, v163
    v_mul_f32 v162, v158, v162
    v_mul_f32 v163, v159, v163
    v_cvt_pk_bf16_f32 v162, v162, v163
    v_lshlrev_b32 v163, 16, v162
    v_and_b32 v162, 0xffff0000, v162
    v_mul_f32 v163, v163, v160
    v_mul_f32 v162, v162, v161
    v_cvt_pk_bf16_f32 v162, v163, v162
    v_and_b32 v164, 15, v2
    v_cmp_gt_u32 vcc, 14, v164
    s_nop 1
    v_cndmask_b32 v162, 0, v162, vcc
    v_lshlrev_b32 v164, 2, v2
    v_cmp_gt_u32 vcc, 32, v2
    s_nop 3
    s_and_saveexec_b64 s[20:21], vcc
    ds_write_b32 v164, v162 offset:1536
    s_mov_b64 exec, s[20:21]
    v_mov_b32 v8, 12
    v_mov_b32 v9, 1
    ds_write_b32 v8, v9
    s_branch L_stamp
L_mo:
    s_setprio 3
    s_lshr_b32 s19, s3, 1
    s_and_b32 s13, s6, 2
    s_add_u32 s13, s13, s19
    s_lshl_b32 s16, s13, 3
    s_add_u32 s16, s16, s4
    s_lshl_b32 s16, s16, 9
    s_add_u32 s16, s16, 1572864
    s_lshl_b32 s12, s4, 1
    s_lshr_b32 s13, s6, 1
    s_add_u32 s12, s12, s13
    s_lshl_b32 s12, s12, 3
    s_add_u32 s12, s12, s7
    s_lshl_b32 s12, s12, 13
    s_lshl_b32 s13, s19, 12
    s_add_u32 s12, s12, s13
    s_add_u32 s12, s12, 2097152
    v_lshrrev_b32 v8, 5, v2
    v_bfe_u32 v10, v2, 3, 2
    v_lshlrev_b32 v8, 6, v8
    v_lshl_add_u32 v152, v10, 4, v8
    v_and_b32 v13, 31, v2
    v_lshlrev_b32 v13, 2, v13
    s_lshl_b32 s13, s19, 7
    v_add_u32 v13, s13, v13
    v_mov_b32 v14, 32
    v_mov_b32 v15, 1
    v_mov_b32 v9, 40
    s_mov_b32 s15, 0
Lw_opub_33:
    ds_read_b32 v8, v9
    s_waitcnt lgkmcnt(0)
    v_readfirstlane_b32 s14, v8
    s_add_u32 s15, s15, 1
    s_nop 2
    s_cmp_ge_u32 s14, 4
    s_cbranch_scc1 Lwd_opub_34
    s_cmp_lt_u32 s15, 16000000
    s_sleep 1
    s_cbranch_scc1 Lw_opub_33
Lwd_opub_34:
    s_mov_b32 s27, s31
    s_mov_b32 s15, 0
Lp_mo_35:
    s_sub_u32 s30, 5242880, s31
    s_and_b32 s14, s15, 3
    s_cmp_eq_u32 s14, 3
    s_cselect_b32 s27, s30, s31
    s_add_u32 s28, s12, s27
    s_add_u32 s29, s16, s27
    buffer_load_dwordx4 v[16:19], v7, s[52:55], s28 offen offset:0 sc1
    buffer_load_dwordx4 v[20:23], v7, s[52:55], s28 offen offset:1024 sc1
    buffer_load_dwordx4 v[24:27], v7, s[52:55], s28 offen offset:2048 sc1
    buffer_load_dwordx4 v[28:31], v7, s[52:55], s28 offen offset:3072 sc1
    buffer_load_dwordx4 v[136:139], v152, s[52:55], s29 offen offset:0 sc1
    buffer_load_dwordx4 v[140:143], v152, s[52:55], s29 offen offset:128 sc1
    buffer_load_dwordx4 v[144:147], v152, s[52:55], s29 offen offset:256 sc1
    buffer_load_dwordx4 v[148:151], v152, s[52:55], s29 offen offset:384 sc1
    s_waitcnt vmcnt(0)
Lpc_mo_37:
    v_min_u32 v153, v17, v19
    v_max_u32 v154, v17, v19
    v_min3_u32 v153, v153, v21, v23
    v_max3_u32 v154, v154, v21, v23
    v_min3_u32 v153, v153, v25, v27
    v_max3_u32 v154, v154, v25, v27
    v_min3_u32 v153, v153, v29, v31
    v_max3_u32 v154, v154, v29, v31
    v_min3_u32 v153, v153, v137, v139
    v_max3_u32 v154, v154, v137, v139
    v_min3_u32 v153, v153, v141, v143
    v_max3_u32 v154, v154, v141, v143
    v_min3_u32 v153, v153, v145, v147
    v_max3_u32 v154, v154, v145, v147
    v_min3_u32 v153, v153, v149, v151
    v_max3_u32 v154, v154, v149, v151
    v_xor_b32 v153, s64, v153
    v_xor_b32 v154, s64, v154
    v_or_b32 v153, v153, v154
    v_cmp_ne_u32 vcc, 0, v153
    s_add_u32 s15, s15, 1
    s_nop 2
    s_cbranch_vccz Lpd_mo_36
    s_cmp_lt_u32 s15, 1000000
    s_cbranch_scc1 Lp_mo_35
Lpd_mo_36:
    s_mov_b32 s96, s15
    v_max_f32 v153, v136, v140
    v_max3_f32 v153, v153, v144, v148
    v_mov_b32 v154, v153
    s_nop 1
    v_permlane32_swap_b32 v153, v154
    v_max_f32 v153, v153, v154
    v_sub_f32 v136, v136, v153
    v_sub_f32 v140, v140, v153
    v_sub_f32 v144, v144, v153
    v_sub_f32 v148, v148, v153
    v_exp_f32 v136, v136
    v_exp_f32 v140, v140
    v_exp_f32 v144, v144
    v_exp_f32 v148, v148
    v_mul_f32 v155, v136, v138
    v_mul_f32 v161, v136, v16
    v_mul_f32 v162, v136, v18
    v_fmac_f32 v155, v140, v142
    v_fmac_f32 v161, v140, v20
    v_fmac_f32 v162, v140, v22
    v_fmac_f32 v155, v144, v146
    v_fmac_f32 v161, v144, v24
    v_fmac_f32 v162, v144, v26
    v_fmac_f32 v155, v148, v150
    v_fmac_f32 v161, v148, v28
    v_fmac_f32 v162, v148, v30
    v_mov_b32 v156, v155
    v_mov_b32 v163, v161
    v_mov_b32 v164, v162
    v_permlane32_swap_b32 v155, v156
    v_permlane32_swap_b32 v161, v163
    v_permlane32_swap_b32 v162, v164
    v_add_f32 v155, v155, v156
    v_add_f32 v161, v161, v163
    v_add_f32 v162, v162, v164
    v_rcp_f32 v155, v155
    s_nop 0
    v_mul_f32 v161, v161, v155
    v_mul_f32 v162, v162, v155
    v_cvt_pk_bf16_f32 v161, v161, v162
    ds_write_b32 v13, v161 offset:1792
    s_mov_b64 exec, 1
    ds_add_u32 v14, v15
    s_mov_b64 exec, -1
    s_branch L_stamp
L_fin:
    s_setprio 3
    s_load_dwordx2 s[44:45], s[0:1], 80
    s_lshl_b32 s12, s6, 18
    s_lshl_b32 s8, s18, 12
    s_add_u32 s12, s12, s8
    s_add_u32 s12, s12, 4194304
    s_mov_b32 s46, 4096
    s_mov_b32 s47, 0x20000
    s_lshr_b32 s8, s18, 5
    s_lshl_b32 s8, s8, 9
    s_bfe_u32 s9, s18, 0x20003
    s_lshl_b32 s9, s9, 7
    s_add_u32 s8, s8, s9
    s_and_b32 s9, s18, 1
    s_lshl_b32 s9, s9, 6
    s_add_u32 s8, s8, s9
    s_bfe_u32 s9, s18, 0x10001
    s_lshl_b32 s9, s9, 3
    s_add_u32 s8, s8, s9
    s_bfe_u32 s9, s18, 0x10002
    s_lshl_b32 s9, s9, 2
    s_add_u32 s8, s8, s9
    s_lshl_b32 s9, s6, 10
    s_add_u32 s28, s8, s9
    v_lshlrev_b32 v10, 4, v2
    v_mov_b32 v9, 40
    s_mov_b32 s15, 0
Lw_fpub_38:
    ds_read_b32 v8, v9
    s_waitcnt lgkmcnt(0)
    v_readfirstlane_b32 s14, v8
    s_add_u32 s15, s15, 1
    s_nop 2
    s_cmp_ge_u32 s14, 8
    s_cbranch_scc1 Lwd_fpub_39
    s_cmp_lt_u32 s15, 16000000
    s_sleep 1
    s_cbranch_scc1 Lw_fpub_38
Lwd_fpub_39:
    s_mov_b32 s15, 0
Lp_f_40:
    buffer_load_dwordx4 v[16:19], v7, s[52:55], s12 offen offset:0 sc1
    buffer_load_dwordx4 v[20:23], v7, s[52:55], s12 offen offset:1024 sc1
    buffer_load_dwordx4 v[24:27], v7, s[52:55], s12 offen offset:2048 sc1
    buffer_load_dwordx4 v[28:31], v7, s[52:55], s12 offen offset:3072 sc1
    s_waitcnt vmcnt(0)
Lpc_f_42:
    v_min_u32 v8, v17, v19
    v_max_u32 v9, v17, v19
    v_min3_u32 v8, v8, v21, v23
    v_max3_u32 v9, v9, v21, v23
    v_min3_u32 v8, v8, v25, v27
    v_max3_u32 v9, v9, v25, v27
    v_min3_u32 v8, v8, v29, v31
    v_max3_u32 v9, v9, v29, v31
    v_xor_b32 v8, s64, v8
    v_xor_b32 v9, s64, v9
    v_or_b32 v8, v8, v9
    v_cmp_ne_u32 vcc, 0, v8
    s_add_u32 s15, s15, 1
    s_nop 2
    s_cbranch_vccz Lpd_f_41
    s_cmp_lt_u32 s15, 1000000
    s_cbranch_scc1 Lp_f_40
Lpd_f_41:
    s_mov_b32 s96, s15
    v_add_f32 v16, v16, v20
    v_add_f32 v24, v24, v28
    v_add_f32 v18, v18, v22
    v_add_f32 v26, v26, v30
    v_add_f32 v16, v16, v24
    v_add_f32 v18, v18, v26
    s_nop 0
    v_add_f32_dpp v48, v16, v16 row_ror:4 row_mask:0xf bank_mask:0xf
    v_add_f32_dpp v50, v18, v18 row_ror:4 row_mask:0xf bank_mask:0xf
    v_mov_b32 v16, v48
    v_mov_b32 v18, v50
    s_nop 0
    v_add_f32_dpp v48, v16, v16 row_ror:8 row_mask:0xf bank_mask:0xf
    v_add_f32_dpp v50, v18, v18 row_ror:8 row_mask:0xf bank_mask:0xf
    v_mov_b32 v16, v48
    v_mov_b32 v18, v50
    v_mov_b32 v48, v16
    v_mov_b32 v50, v18
    s_nop 0
    v_permlane16_swap_b32 v16, v48
    v_permlane16_swap_b32 v18, v50
    v_add_f32 v16, v16, v48
    v_add_f32 v18, v18, v50
    v_mov_b32 v48, v16
    v_mov_b32 v50, v18
    s_nop 0
    v_permlane32_swap_b32 v16, v48
    v_permlane32_swap_b32 v18, v50
    v_add_f32 v16, v16, v48
    v_add_f32 v18, v18, v50
    v_cvt_pk_bf16_f32 v8, v16, v18
    v_cmp_gt_u32 vcc, 4, v2
    s_waitcnt lgkmcnt(0)
    s_nop 2
    s_and_saveexec_b64 s[20:21], vcc
    buffer_store_dword v8, v10, s[44:47], s28 offen
    s_mov_b64 exec, s[20:21]
    s_cmp_eq_u32 s2, 0
    s_cbranch_scc0 L_stamp
    v_mov_b32 v8, s64
    v_mov_b32 v9, 0
    v_cmp_eq_u32 vcc, 0, v2
    s_nop 3
    s_and_saveexec_b64 s[20:21], vcc
    buffer_store_dword v8, v9, s[52:55], 0 offen
    s_mov_b64 exec, s[20:21]
L_stamp:
L_end:
    s_endpgm
.section .rodata,"a"
.p2align 6
.amdhsa_kernel gated_mix__sliding_block_cached__glu_gated_swiglu__decode_kernel
  .amdhsa_next_free_vgpr 168
  .amdhsa_next_free_sgpr 102
  .amdhsa_accum_offset 168
  .amdhsa_group_segment_fixed_size 0
  .amdhsa_kernarg_size 104
  .amdhsa_user_sgpr_count 2
  .amdhsa_user_sgpr_kernarg_segment_ptr 1
  .amdhsa_system_sgpr_workgroup_id_x 1
.end_amdhsa_kernel
```
